```python
import torch

def _softmax(x, axis=-1):
    return torch.softmax(x, dim=axis)
def _gelu(x):
    return torch.nn.functional.gelu(x, approximate="tanh")
def _silu(x):
    return torch.nn.functional.silu(x)
def _sigmoid(x):
    return torch.sigmoid(x)
def _layernorm(x, axis=-1, eps=1e-5):
    m = x.mean(dim=axis, keepdim=True)
    v = x.var(dim=axis, keepdim=True, unbiased=False)
    return (x - m) / torch.sqrt(v + eps)
def _scatter_add(tgt, idx, src, axis=0):
    return tgt.clone().index_add_(axis, idx, src)
def _segment_sum(src, seg, n):
    out = torch.zeros((n,) + src.shape[1:], dtype=src.dtype)
    return out.index_add_(0, seg, src)
def _pad(x, pw):
    flat = tuple(v for pair in reversed(pw) for v in pair)
    return torch.nn.functional.pad(x, flat)

kernel_name = 'recurrent_scan__sliding_block_cached__mixer_token_mlp__decode'

def setup_inputs():

    _w = (lambda a: (lambda t: t.to(torch.bfloat16) if t.is_floating_point() else t)(torch.as_tensor(a)))
    def _A_setup():
        B, Sq, D = 2, 1, 512
        Hq, Hkv, Sk, Dh = 32, 32, 4096, 128
        assert Hq % Hkv == 0, (Hq, Hkv)
        return {
            "x": _w((lambda *s: torch.randn(*s, dtype=torch.bfloat16) * 0.4)(B, Sq, D)),
            "k_cache": _w((lambda *s: torch.randn(*s, dtype=torch.bfloat16) * 1.6)(B, Hkv, Sk, Dh)),
            "v_cache": _w((lambda *s: torch.randn(*s, dtype=torch.bfloat16) * 1.6)(B, Hkv, Sk, Dh)),
            "wq": _w((lambda *s: torch.randn(*s, dtype=torch.bfloat16) * 1.6)(D, Hq * Dh) * (D ** -0.5)),
            "wo": _w((lambda *s: torch.randn(*s, dtype=torch.bfloat16) * 1.6)(Hq * Dh, D) * ((Hq * Dh) ** -0.5)),
        }
    _A_in = _A_setup()

    def _B_setup():
        B, S, D, F = 2, 1, 512, 1376
        return {
            "x": _w((lambda *s: torch.randn(*s, dtype=torch.bfloat16) * 0.4)(B, S, D)),
            "w1": _w((lambda *s: torch.randn(*s, dtype=torch.bfloat16) * 1.6)(S, F) * (S ** -0.5)),
            "b1": _w((lambda *s: torch.randn(*s, dtype=torch.bfloat16) * 1.6)(F) * 0.02),
            "w2": _w((lambda *s: torch.randn(*s, dtype=torch.bfloat16) * 1.6)(F, S) * (F ** -0.5)),
            "b2": _w((lambda *s: torch.randn(*s, dtype=torch.bfloat16) * 1.6)(S) * 0.02),
        }
    _B_in = _B_setup()

    return {
        "A_x": _A_in["x"],
        "A_k_cache": _A_in["k_cache"],
        "A_v_cache": _A_in["v_cache"],
        "A_wq": _A_in["wq"],
        "A_wo": _A_in["wo"],
        "B_x": _B_in["x"],
        "B_w1": _B_in["w1"],
        "B_b1": _B_in["b1"],
        "B_w2": _B_in["w2"],
        "B_b2": _B_in["b2"],
    }

def reference(A_x, A_k_cache, A_v_cache, A_wq, A_wo, B_x, B_w1, B_b1, B_w2, B_b2):
    def _A_ref(x, k_cache, v_cache, wq, wo):
        B, Sq, D = x.shape
        Hq, Dh = 32, 128
        Hkv, Sk = k_cache.shape[1], k_cache.shape[2]
        W = min(4096, max(256, Sk // 4))
        rep = Hq // Hkv
        q = (lambda x, *d: x.permute(*d))((x @ wq).reshape(B, Sq, Hq, Dh), 0, 2, 1, 3)
        k = (lambda x, n, axis: torch.repeat_interleave(x, n, dim=axis))(k_cache[:, :, Sk - W:, :], rep, axis=1)
        v = (lambda x, n, axis: torch.repeat_interleave(x, n, dim=axis))(v_cache[:, :, Sk - W:, :], rep, axis=1)
        scores = torch.einsum("bhqd,bhkd->bhqk", q, k) * (Dh ** -0.5)
        p = _softmax(scores, axis=-1)
        o = torch.einsum("bhqk,bhkd->bhqd", p, v)
        return (lambda x, *d: x.permute(*d))(o, 0, 2, 1, 3).reshape(B, Sq, Hq * Dh) @ wo

    def _B_ref(x, w1, b1, w2, b2):
        B, S, D = x.shape
        h = _layernorm(x, axis=-1)
        u = torch.einsum("bsd,sf->bdf", h, w1) + b1
        u = _gelu(u)
        y = torch.einsum("bdf,fs->bds", u, w2) + b2
        return (lambda x, *d: x.permute(*d))(y, 0, 2, 1)

    x = A_x
    xn = _layernorm(x, axis=-1)
    s = _A_ref(xn, A_k_cache, A_v_cache, A_wq, A_wo)
    g = _silu(_B_ref(xn, B_w1, B_b1, B_w2, B_b2))
    return x + s * g
```

```asm
; @launch grid=(256,1,1) block=(448,1,1) lds=152960
.amdgcn_target "amdgcn-amd-amdhsa--gfx950"
.text
.globl recurrent_scan__sliding_block_cached__mixer_token_mlp__decode_kernel
.p2align 12
.fill 832, 4, 0xbf810000
.p2align 8
.type recurrent_scan__sliding_block_cached__mixer_token_mlp__decode_kernel,@function
recurrent_scan__sliding_block_cached__mixer_token_mlp__decode_kernel:
    s_cmp_ge_u32 s2, 256
    s_cbranch_scc1 L_end
    s_load_dwordx16 s[4:19], s[0:1], 0
    v_lshrrev_b32 v1, 6, v0
    v_and_b32 v0, 63, v0
    v_readfirstlane_b32 s3, v1
    s_and_b32 s30, s2, 7
    s_lshl_b32 s30, s30, 2
    s_lshr_b32 s31, s2, 6
    s_add_u32 s30, s30, s31
    s_bfe_u32 s31, s2, 0x30003
    s_lshr_b32 s32, s31, 2
    s_and_b32 s33, s31, 3
    v_lshrrev_b32 v1, 4, v0
    v_and_b32 v2, 15, v0
    v_lshlrev_b32 v3, 4, v0
    s_cmp_lg_u32 s3, 0
    s_cbranch_scc1 L_others
    s_setprio 3
    v_mov_b32 v4, -1
    v_mov_b32 v5, -1
    v_lshlrev_b32 v16, 3, v0
    v_add_u32 v16, 149504, v16
    ds_write_b64 v16, v[4:5]
    v_and_b32 v5, 7, v0
    v_lshrrev_b32 v6, 3, v0
    v_xor_b32 v8, v1, v2
    v_lshlrev_b32 v8, 4, v8
    v_lshl_add_u32 v8, v1, 8, v8
    v_xor_b32 v9, 64, v8
    v_xor_b32 v10, 0x80, v8
    v_xor_b32 v11, 0xc0, v8
    v_lshlrev_b32 v16, 2, v0
    v_add_u32 v16, 149504, v16
    s_lshl_b32 s52, s32, 5
    s_add_u32 s52, s52, s30
    s_lshl_b32 s52, s52, 20
    s_lshl_b32 s54, s33, 16
    s_add_u32 s52, s52, s54
    s_add_u32 s52, s52, 0xC0000
    s_mov_b32 s54, 0
    v_mov_b32 v17, 0
    s_lshl_b32 s55, s2, 9
    s_and_b32 s55, s55, 0xf000
    s_add_u32 s53, s52, s55
    s_mov_b32 s46, 4194304
    s_mov_b32 s47, 0x20000
    s_mov_b32 s50, 67108864
    s_mov_b32 s51, 0x20000
    s_waitcnt lgkmcnt(0)
    s_mov_b64 s[48:49], s[6:7]
L_ld_k:
    s_mov_b32 m0, s54
    s_add_u32 s54, s54, 4096
    buffer_load_dwordx4 v8, s[48:51], s53 offen nt lds
    buffer_load_dwordx4 v9, s[48:51], s53 offen offset:1024 nt lds
    buffer_load_dwordx4 v10, s[48:51], s53 offen offset:2048 nt lds
    buffer_load_dwordx4 v11, s[48:51], s53 offen offset:3072 nt lds
    s_add_u32 s55, s55, 4096
    s_and_b32 s55, s55, 0xffff
    s_add_u32 s53, s52, s55
    v_add_u32 v17, 1, v17
    s_cmp_lg_u32 s54, 12288
    s_cbranch_scc1 L_nb
    s_barrier
L_nb:
    s_waitcnt vmcnt(32)
    s_cmp_gt_u32 s54, 32768
    s_cselect_b32 s58, -3, 1
    v_add_u32 v18, s58, v17
    s_cbranch_scc1 L_w_1
    s_waitcnt vmcnt(16)
L_w_1:
    ds_write_b32 v16, v18
    s_cmp_lt_u32 s54, 65536
    s_cbranch_scc1 L_ld_k
    s_mov_b64 s[48:49], s[8:9]
    v_lshlrev_b32 v8, 1, v1
    v_xor_b32 v8, v8, v2
    v_lshlrev_b32 v8, 4, v8
    v_lshl_add_u32 v8, v1, 8, v8
    v_xor_b32 v9, 0x80, v8
L_ld_v:
    s_mov_b32 m0, s54
    s_add_u32 s54, s54, 4096
    buffer_load_dwordx4 v8, s[48:51], s53 offen nt lds
    buffer_load_dwordx4 v8, s[48:51], s53 offen offset:1024 nt lds
    buffer_load_dwordx4 v9, s[48:51], s53 offen offset:2048 nt lds
    buffer_load_dwordx4 v9, s[48:51], s53 offen offset:3072 nt lds
    s_add_u32 s55, s55, 4096
    s_and_b32 s55, s55, 0xffff
    s_add_u32 s53, s52, s55
    v_add_u32 v17, 1, v17
    s_waitcnt vmcnt(32)
    s_cmp_gt_u32 s54, 32768
    s_cselect_b32 s58, -3, 1
    v_add_u32 v18, s58, v17
    s_cbranch_scc1 L_w_2
    s_waitcnt vmcnt(16)
L_w_2:
    ds_write_b32 v16, v18
    s_cmp_lt_u32 s54, 131072
    s_cbranch_scc1 L_ld_v
    s_mov_b64 s[44:45], s[12:13]
    v_lshlrev_b32 v4, 1, v1
    v_xor_b32 v4, v4, v5
    v_lshlrev_b32 v4, 4, v4
    v_lshl_add_u32 v12, v6, 10, v4
    v_add_u32 v13, 7168, v12
    v_add_u32 v14, 14336, v12
    v_add_u32 v15, 21504, v12
    s_lshl_b32 s53, s30, 17
    s_lshl_b32 s52, s31, 7
    s_add_u32 s53, s53, s52
    v_mov_b32 v16, 149504
    s_mov_b64 s[58:59], vcc
L_spin_3:
    ds_read_b32 v4, v16 offset:260
    s_waitcnt lgkmcnt(0)
    v_cmp_ne_u32 vcc, -1, v4
    s_cbranch_vccz L_spin_3
    s_mov_b64 vcc, s[58:59]
L_ld_o:
    s_mov_b32 m0, s54
    s_add_u32 s54, s54, 4096
    buffer_load_dwordx4 v12, s[44:47], s53 offen nt lds
    buffer_load_dwordx4 v13, s[44:47], s53 offen offset:1024 nt lds
    buffer_load_dwordx4 v14, s[44:47], s53 offen offset:2048 nt lds
    buffer_load_dwordx4 v15, s[44:47], s53 offen offset:3072 nt lds
    s_add_u32 s53, s53, 32768
    s_waitcnt vmcnt(32)
    s_cmp_lt_u32 s54, 147456
    s_cbranch_scc1 L_ld_o
    s_barrier
    s_waitcnt vmcnt(16)
    s_barrier
    s_waitcnt vmcnt(0)
    s_barrier
    s_barrier
    s_barrier
    s_endpgm
L_others:
    s_load_dwordx8 s[20:27], s[0:1], 64
    s_load_dwordx2 s[28:29], s[0:1], 96
    s_mov_b32 s35, 0xffff0000
    v_mov_b32 v12, 149504
    s_mov_b32 s38, 268435456
    s_mov_b32 s39, 0x20000
    s_cmp_eq_u32 s3, 2
    s_cbranch_scc1 L_gwave
    s_cmp_lg_u32 s3, 1
    s_cbranch_scc1 L_kwave
    s_setprio 2
    v_and_b32 v100, 1, v1
    v_lshlrev_b32 v100, 1, v100
    v_and_b32 v101, 7, v0
    v_xor_b32 v100, v100, v101
    v_lshlrev_b32 v100, 4, v100
    v_lshrrev_b32 v102, 3, v0
    v_lshl_add_u32 v104, v102, 13, v100
    v_xor_b32 v105, 64, v104
    v_add_u32 v105, 64512, v105
    v_add_u32 v106, 129024, v104
    v_add_u32 v107, 129024, v105
    s_lshl_b32 s53, s33, 20
    s_lshl_b32 s54, s30, 8
    s_add_u32 s53, s53, s54
    s_lshl_b32 s54, s32, 7
    s_add_u32 s53, s53, s54
    s_mov_b32 s54, 131072
    s_mov_b32 m0, 147456
    s_mov_b32 s42, 2048
    s_mov_b32 s43, 0x20000
    s_mov_b32 s46, 4194304
    s_mov_b32 s47, 0x20000
    s_waitcnt lgkmcnt(0)
    s_mov_b64 s[40:41], s[4:5]
    s_mov_b64 s[44:45], s[10:11]
    buffer_load_dwordx4 v3, s[40:43], 0 offen lds
    buffer_load_dwordx4 v3, s[40:43], 0 offen offset:1024 lds
L_ld_q:
    s_mov_b32 m0, s54
    s_add_u32 s54, s54, 4096
    buffer_load_dwordx4 v104, s[44:47], s53 offen nt lds
    buffer_load_dwordx4 v105, s[44:47], s53 offen offset:1024 nt lds
    buffer_load_dwordx4 v106, s[44:47], s53 offen offset:2048 nt lds
    buffer_load_dwordx4 v107, s[44:47], s53 offen offset:3072 nt lds
    s_add_u32 s53, s53, 262144
    s_cmp_lt_u32 s54, 147456
    s_cbranch_scc1 L_ld_q
    s_barrier
    v_bfe_u32 v8, v0, 2, 1
    v_lshlrev_b32 v8, 10, v8
    v_and_b32 v9, 3, v0
    v_lshrrev_b32 v10, 3, v0
    v_lshl_add_u32 v11, v10, 2, v9
    v_lshl_add_u32 v40, v11, 5, v8
    v_add_u32 v40, 147456, v40
    v_lshl_add_u32 v41, v9, 6, v8
    v_lshl_add_u32 v41, v1, 4, v41
    s_lshl_b32 s52, s33, 8
    s_add_u32 s52, s52, 147456
    v_add_u32 v41, s52, v41
    v_lshrrev_b32 v44, 2, v2
    v_lshrrev_b32 v45, 1, v44
    v_and_b32 v46, 1, v1
    v_lshl_add_u32 v45, v46, 1, v45
    v_lshl_add_u32 v44, v1, 3, v44
    v_lshlrev_b32 v44, 7, v44
    v_lshl_add_u32 v44, v45, 5, v44
    v_lshl_add_u32 v44, v9, 3, v44
    v_add_u32 v44, 131072, v44
    v_xor_b32 v45, 32, v44
    v_xor_b32 v46, 64, v44
    v_xor_b32 v47, 0x60, v44
    v_lshlrev_b32 v188, 11, v1
    v_lshl_add_u32 v188, v2, 4, v188
    s_lshl_b32 s61, s30, 12
    s_lshl_b32 s53, s33, 9
    s_add_u32 s53, s53, s61
    s_lshl_b32 s54, s32, 8
    s_add_u32 s53, s53, s54
    s_add_u32 s53, s53, 65536
    s_lshl_b32 s54, s32, 11
    s_add_u32 s61, s61, s54
    s_add_u32 s61, s61, 65536
    s_getreg_b32 s55, hwreg(HW_REG_XCC_ID, 0, 4)
    s_movk_i32 s56, 0xff
    s_waitcnt lgkmcnt(0)
    s_load_dword s34, s[28:29], 0
    s_mov_b64 s[36:37], s[28:29]
    v_mov_b32 v8, 1
    s_waitcnt vmcnt(16)
    ds_write_b32 v12, v8 offset:264
    ds_read_b128 v[8:11], v40
    ds_read_b128 v[12:15], v40 offset:16
    ds_read_b128 v[16:19], v41
    s_waitcnt lgkmcnt(1)
    v_lshlrev_b32 v20, 16, v8
    v_and_b32 v21, s35, v8
    v_lshlrev_b32 v22, 16, v9
    v_and_b32 v23, s35, v9
    v_lshlrev_b32 v24, 16, v10
    v_and_b32 v25, s35, v10
    v_lshlrev_b32 v26, 16, v11
    v_and_b32 v27, s35, v11
    v_lshlrev_b32 v28, 16, v12
    v_and_b32 v29, s35, v12
    v_lshlrev_b32 v30, 16, v13
    v_and_b32 v31, s35, v13
    v_lshlrev_b32 v32, 16, v14
    v_and_b32 v33, s35, v14
    v_lshlrev_b32 v34, 16, v15
    v_and_b32 v35, s35, v15
    v_pk_add_f32 v[48:49], v[20:21], v[22:23]
    v_pk_add_f32 v[50:51], v[24:25], v[26:27]
    v_pk_add_f32 v[48:49], v[48:49], v[28:29]
    v_pk_add_f32 v[50:51], v[50:51], v[30:31]
    v_pk_add_f32 v[48:49], v[48:49], v[32:33]
    v_pk_add_f32 v[50:51], v[50:51], v[34:35]
    v_pk_add_f32 v[48:49], v[48:49], v[50:51]
    v_add_f32 v36, v48, v49
    s_nop 1
    v_add_f32_dpp v36, v36, v36 quad_perm:[1,0,3,2] row_mask:0xf bank_mask:0xf
    s_nop 1
    v_add_f32_dpp v36, v36, v36 quad_perm:[2,3,0,1] row_mask:0xf bank_mask:0xf
    s_nop 1
    v_add_f32_dpp v36, v36, v36 row_ror:8 row_mask:0xf bank_mask:0xf
    v_mov_b32 v37, v36
    s_nop 1
    v_permlane16_swap_b32 v37, v36
    v_add_f32 v36, v36, v37
    v_mov_b32 v37, v36
    s_nop 1
    v_permlane32_swap_b32 v37, v36
    v_add_f32 v36, v36, v37
    v_mul_f32 v36, 0x3b000000, v36
    v_pk_add_f32 v[48:49], v[20:21], v[36:37] op_sel_hi:[1,0] neg_lo:[0,1] neg_hi:[0,1]
    v_pk_add_f32 v[50:51], v[22:23], v[36:37] op_sel_hi:[1,0] neg_lo:[0,1] neg_hi:[0,1]
    v_pk_add_f32 v[52:53], v[24:25], v[36:37] op_sel_hi:[1,0] neg_lo:[0,1] neg_hi:[0,1]
    v_pk_add_f32 v[54:55], v[26:27], v[36:37] op_sel_hi:[1,0] neg_lo:[0,1] neg_hi:[0,1]
    v_pk_add_f32 v[56:57], v[28:29], v[36:37] op_sel_hi:[1,0] neg_lo:[0,1] neg_hi:[0,1]
    v_pk_add_f32 v[58:59], v[30:31], v[36:37] op_sel_hi:[1,0] neg_lo:[0,1] neg_hi:[0,1]
    v_pk_add_f32 v[60:61], v[32:33], v[36:37] op_sel_hi:[1,0] neg_lo:[0,1] neg_hi:[0,1]
    v_pk_add_f32 v[62:63], v[34:35], v[36:37] op_sel_hi:[1,0] neg_lo:[0,1] neg_hi:[0,1]
    v_pk_mul_f32 v[48:49], v[48:49], v[48:49]
    v_pk_mul_f32 v[50:51], v[50:51], v[50:51]
    v_pk_fma_f32 v[48:49], v[52:53], v[52:53], v[48:49]
    v_pk_fma_f32 v[50:51], v[54:55], v[54:55], v[50:51]
    v_pk_fma_f32 v[48:49], v[56:57], v[56:57], v[48:49]
    v_pk_fma_f32 v[50:51], v[58:59], v[58:59], v[50:51]
    v_pk_fma_f32 v[48:49], v[60:61], v[60:61], v[48:49]
    v_pk_fma_f32 v[50:51], v[62:63], v[62:63], v[50:51]
    v_pk_add_f32 v[48:49], v[48:49], v[50:51]
    v_add_f32 v38, v48, v49
    s_nop 1
    v_add_f32_dpp v38, v38, v38 quad_perm:[1,0,3,2] row_mask:0xf bank_mask:0xf
    s_nop 1
    v_add_f32_dpp v38, v38, v38 quad_perm:[2,3,0,1] row_mask:0xf bank_mask:0xf
    s_nop 1
    v_add_f32_dpp v38, v38, v38 row_ror:8 row_mask:0xf bank_mask:0xf
    v_mov_b32 v37, v38
    s_nop 1
    v_permlane16_swap_b32 v37, v38
    v_add_f32 v38, v38, v37
    v_mov_b32 v37, v38
    s_nop 1
    v_permlane32_swap_b32 v37, v38
    v_add_f32 v38, v38, v37
    v_mul_f32 v38, 0x3b000000, v38
    v_cvt_pk_bf16_f32 v37, v36, v38
    v_lshlrev_b32 v40, 16, v37
    v_and_b32 v42, s35, v37
    v_add_f32 v42, 0x3727c5ac, v42
    v_cvt_pk_bf16_f32 v37, v42, v42
    v_lshlrev_b32 v42, 16, v37
    v_sqrt_f32 v42, v42
    s_nop 0
    v_cvt_pk_bf16_f32 v37, v42, v42
    v_lshlrev_b32 v42, 16, v37
    v_rcp_f32 v42, v42
    s_waitcnt lgkmcnt(0)
    v_lshlrev_b32 v20, 16, v16
    v_and_b32 v21, s35, v16
    v_lshlrev_b32 v22, 16, v17
    v_and_b32 v23, s35, v17
    v_lshlrev_b32 v24, 16, v18
    v_and_b32 v25, s35, v18
    v_lshlrev_b32 v26, 16, v19
    v_and_b32 v27, s35, v19
    v_pk_add_f32 v[20:21], v[20:21], v[40:41] op_sel_hi:[1,0] neg_lo:[0,1] neg_hi:[0,1]
    v_pk_add_f32 v[22:23], v[22:23], v[40:41] op_sel_hi:[1,0] neg_lo:[0,1] neg_hi:[0,1]
    v_pk_add_f32 v[24:25], v[24:25], v[40:41] op_sel_hi:[1,0] neg_lo:[0,1] neg_hi:[0,1]
    v_pk_add_f32 v[26:27], v[26:27], v[40:41] op_sel_hi:[1,0] neg_lo:[0,1] neg_hi:[0,1]
    v_cvt_pk_bf16_f32 v16, v20, v21
    v_cvt_pk_bf16_f32 v17, v22, v23
    v_cvt_pk_bf16_f32 v18, v24, v25
    v_cvt_pk_bf16_f32 v19, v26, v27
    v_lshlrev_b32 v20, 16, v16
    v_and_b32 v21, s35, v16
    v_lshlrev_b32 v22, 16, v17
    v_and_b32 v23, s35, v17
    v_lshlrev_b32 v24, 16, v18
    v_and_b32 v25, s35, v18
    v_lshlrev_b32 v26, 16, v19
    v_and_b32 v27, s35, v19
    v_pk_mul_f32 v[20:21], v[20:21], v[42:43] op_sel_hi:[1,0]
    v_pk_mul_f32 v[22:23], v[22:23], v[42:43] op_sel_hi:[1,0]
    v_pk_mul_f32 v[24:25], v[24:25], v[42:43] op_sel_hi:[1,0]
    v_pk_mul_f32 v[26:27], v[26:27], v[42:43] op_sel_hi:[1,0]
    v_cvt_pk_bf16_f32 v16, v20, v21
    v_cvt_pk_bf16_f32 v17, v22, v23
    v_cvt_pk_bf16_f32 v18, v24, v25
    v_cvt_pk_bf16_f32 v19, v26, v27
    v_mov_b32 v12, 149504
    s_mul_i32 s34, s34, 1664525
    s_add_u32 s34, s34, 1013904223
    s_add_u32 s55, s55, s34
    s_add_u32 s55, s55, 1
    v_mov_b32 v184, s55
    v_lshrrev_b32 v185, 8, v184
    v_lshrrev_b32 v186, 16, v184
    v_lshrrev_b32 v187, 24, v184
    s_xor_b32 s55, s55, s34
    v_lshlrev_b32 v24, 7, v1
    v_and_b32 v24, 0x80, v24
    v_lshrrev_b32 v25, 5, v0
    v_lshl_add_u32 v24, v25, 6, v24
    v_lshl_add_u32 v24, v2, 1, v24
    v_add_u32 v24, v12, v24
    s_waitcnt vmcnt(0)
    ds_read_b64_tr_b16 v[48:49], v44 offset:0
    ds_read_b64_tr_b16 v[50:51], v44 offset:512
    ds_read_b64_tr_b16 v[52:53], v45 offset:0
    ds_read_b64_tr_b16 v[54:55], v45 offset:512
    ds_read_b64_tr_b16 v[56:57], v46 offset:0
    ds_read_b64_tr_b16 v[58:59], v46 offset:512
    ds_read_b64_tr_b16 v[60:61], v47 offset:0
    ds_read_b64_tr_b16 v[62:63], v47 offset:512
    ds_read_b64_tr_b16 v[64:65], v44 offset:4096
    ds_read_b64_tr_b16 v[66:67], v44 offset:4608
    ds_read_b64_tr_b16 v[68:69], v45 offset:4096
    ds_read_b64_tr_b16 v[70:71], v45 offset:4608
    ds_read_b64_tr_b16 v[72:73], v46 offset:4096
    ds_read_b64_tr_b16 v[74:75], v46 offset:4608
    ds_read_b64_tr_b16 v[76:77], v47 offset:4096
    ds_read_b64_tr_b16 v[78:79], v47 offset:4608
    s_waitcnt lgkmcnt(14)
    v_mfma_f32_16x16x32_bf16 v[112:115], v[16:19], v[48:51], 0
    s_waitcnt lgkmcnt(12)
    v_mfma_f32_16x16x32_bf16 v[116:119], v[16:19], v[52:55], 0
    s_waitcnt lgkmcnt(10)
    v_mfma_f32_16x16x32_bf16 v[120:123], v[16:19], v[56:59], 0
    s_waitcnt lgkmcnt(8)
    v_mfma_f32_16x16x32_bf16 v[124:127], v[16:19], v[60:63], 0
    ds_read_b64_tr_b16 v[80:81], v44 offset:8192
    ds_read_b64_tr_b16 v[82:83], v44 offset:8704
    ds_read_b64_tr_b16 v[84:85], v45 offset:8192
    ds_read_b64_tr_b16 v[86:87], v45 offset:8704
    ds_read_b64_tr_b16 v[88:89], v46 offset:8192
    ds_read_b64_tr_b16 v[90:91], v46 offset:8704
    ds_read_b64_tr_b16 v[92:93], v47 offset:8192
    ds_read_b64_tr_b16 v[94:95], v47 offset:8704
    s_waitcnt lgkmcnt(14)
    v_mfma_f32_16x16x32_bf16 v[128:131], v[16:19], v[64:67], 0
    s_waitcnt lgkmcnt(12)
    v_mfma_f32_16x16x32_bf16 v[132:135], v[16:19], v[68:71], 0
    s_waitcnt lgkmcnt(10)
    v_mfma_f32_16x16x32_bf16 v[136:139], v[16:19], v[72:75], 0
    s_waitcnt lgkmcnt(8)
    v_mfma_f32_16x16x32_bf16 v[140:143], v[16:19], v[76:79], 0
    ds_read_b64_tr_b16 v[96:97], v44 offset:12288
    ds_read_b64_tr_b16 v[98:99], v44 offset:12800
    ds_read_b64_tr_b16 v[100:101], v45 offset:12288
    ds_read_b64_tr_b16 v[102:103], v45 offset:12800
    ds_read_b64_tr_b16 v[104:105], v46 offset:12288
    ds_read_b64_tr_b16 v[106:107], v46 offset:12800
    ds_read_b64_tr_b16 v[108:109], v47 offset:12288
    ds_read_b64_tr_b16 v[110:111], v47 offset:12800
    s_waitcnt lgkmcnt(14)
    v_mfma_f32_16x16x32_bf16 v[144:147], v[16:19], v[80:83], 0
    s_waitcnt lgkmcnt(12)
    v_mfma_f32_16x16x32_bf16 v[148:151], v[16:19], v[84:87], 0
    s_waitcnt lgkmcnt(10)
    v_mfma_f32_16x16x32_bf16 v[152:155], v[16:19], v[88:91], 0
    s_waitcnt lgkmcnt(8)
    v_mfma_f32_16x16x32_bf16 v[156:159], v[16:19], v[92:95], 0
    v_mov_b32 v25, 1
    s_waitcnt lgkmcnt(6)
    v_mfma_f32_16x16x32_bf16 v[160:163], v[16:19], v[96:99], 0
    s_waitcnt lgkmcnt(4)
    v_mfma_f32_16x16x32_bf16 v[164:167], v[16:19], v[100:103], 0
    s_waitcnt lgkmcnt(2)
    v_mfma_f32_16x16x32_bf16 v[168:171], v[16:19], v[104:107], 0
    s_waitcnt lgkmcnt(0)
    v_mfma_f32_16x16x32_bf16 v[172:175], v[16:19], v[108:111], 0
    s_mov_b64 exec, 1
    ds_write_b32 v12, v25 offset:260
    s_mov_b64 exec, -1
    v_add_f32 v180, v112, v129
    v_add_f32 v181, v116, v133
    v_add_f32 v182, v120, v137
    v_add_f32 v183, v124, v141
    v_add_f32 v180, v180, v146
    v_add_f32 v181, v181, v150
    v_add_f32 v182, v182, v154
    v_add_f32 v183, v183, v158
    v_add_f32 v180, v180, v163
    v_add_f32 v181, v181, v167
    v_add_f32 v182, v182, v171
    v_add_f32 v183, v183, v175
    v_bfi_b32 v180, s56, v184, v180
    v_bfi_b32 v181, s56, v185, v181
    v_bfi_b32 v182, s56, v186, v182
    v_bfi_b32 v183, s56, v187, v183
    s_mov_b32 exec_hi, 0
    buffer_store_dwordx4 v[180:183], v188, s[36:39], s53 offen
    s_mov_b32 exec_hi, -1
    s_mov_b32 s60, 0
    s_mov_b64 s[58:59], -1
    buffer_load_dwordx4 v[48:51], v3, s[36:39], s61 offen sc1
    buffer_load_dwordx4 v[52:55], v3, s[36:39], s61 offen offset:1024 sc1
L_q_chk:
    s_waitcnt vmcnt(0)
    v_cmpx_eq_u32_sdwa vcc, v48, v184 src0_sel:BYTE_0 src1_sel:BYTE_0
    v_cmpx_eq_u32_sdwa vcc, v49, v184 src0_sel:BYTE_0 src1_sel:BYTE_1
    v_cmpx_eq_u32_sdwa vcc, v50, v184 src0_sel:BYTE_0 src1_sel:BYTE_2
    v_cmpx_eq_u32_sdwa vcc, v51, v184 src0_sel:BYTE_0 src1_sel:BYTE_3
    v_cmpx_eq_u32_sdwa vcc, v52, v184 src0_sel:BYTE_0 src1_sel:BYTE_0
    v_cmpx_eq_u32_sdwa vcc, v53, v184 src0_sel:BYTE_0 src1_sel:BYTE_1
    v_cmpx_eq_u32_sdwa vcc, v54, v184 src0_sel:BYTE_0 src1_sel:BYTE_2
    v_cmpx_eq_u32_sdwa vcc, v55, v184 src0_sel:BYTE_0 src1_sel:BYTE_3
    s_andn2_b64 s[58:59], s[58:59], exec
    s_cbranch_scc0 L_q_go
    s_add_u32 s60, s60, 1
    s_cmp_ge_u32 s60, 48
    s_cbranch_scc1 L_q_slow
L_q_rty:
    s_mov_b64 exec, s[58:59]
    buffer_load_dwordx4 v[48:51], v3, s[36:39], s61 offen sc1
    buffer_load_dwordx4 v[52:55], v3, s[36:39], s61 offen offset:1024 sc1
    s_branch L_q_chk
L_q_go:
    s_mov_b64 exec, -1
    v_pk_add_f32 v[48:49], v[48:49], v[52:53]
    v_pk_add_f32 v[50:51], v[50:51], v[54:55]
    s_nop 1
    v_permlane32_swap_b32 v48, v50
    v_permlane32_swap_b32 v49, v51
    v_pk_add_f32 v[48:49], v[48:49], v[50:51]
    v_cvt_pk_bf16_f32 v48, v48, v49
    ds_write_b16 v24, v48 offset:512
    ds_write_b16_d16_hi v24, v48 offset:544
    s_mov_b64 exec, 1
    ds_write_b32 v12, v25 offset:256
    s_barrier
    s_barrier
    s_barrier
    s_barrier
    s_barrier
    s_endpgm
L_kwave:
    s_barrier
    s_setprio 1
    s_sub_u32 s56, s3, 3
    v_xor_b32 v8, v1, v2
    v_lshlrev_b32 v8, 4, v8
    v_lshl_add_u32 v8, v2, 8, v8
    s_lshl_b32 s40, s56, 14
    v_add_u32 v8, s40, v8
    v_xor_b32 v9, 64, v8
    v_xor_b32 v10, 0x80, v8
    v_xor_b32 v11, 0xc0, v8
    v_cmp_eq_u32 s[42:43], 1, v1
    v_cmp_eq_u32 s[44:45], 2, v1
    v_cmp_eq_u32 s[46:47], 3, v1
    v_lshlrev_b32 v13, 4, v1
    v_add_u32 v13, 149504, v13
    v_lshlrev_b32 v15, 1, v0
    s_lshl_b32 s40, s56, 7
    s_add_u32 s40, s40, 150272
    v_add_u32 v15, s40, v15
    s_lshl_b32 s40, s56, 2
    s_add_u32 s41, s40, 9
    v_add_u32 v20, s40, v12
    v_lshrrev_b32 v21, 2, v2
    v_and_b32 v22, 1, v1
    v_lshl_add_u32 v22, v22, 2, v21
    s_lshl_b32 s40, s56, 1
    v_xor_b32 v22, s40, v22
    v_lshl_add_u32 v23, v1, 3, v21
    v_lshlrev_b32 v24, 8, v23
    v_lshl_add_u32 v24, v22, 5, v24
    v_and_b32 v25, 3, v0
    v_lshl_add_u32 v24, v25, 3, v24
    v_add_u32 v24, 65536, v24
    v_lshl_add_u32 v23, v1, 2, v21
    v_bfe_u32 v22, v23, 1, 2
    v_xor_b32 v22, s56, v22
    v_lshlrev_b32 v26, 7, v23
    v_lshl_add_u32 v26, v22, 5, v26
    v_lshl_add_u32 v26, v25, 3, v26
    v_add_u32 v26, 131072, v26
    v_xor_b32 v25, 32, v24
    v_lshlrev_b32 v27, 4, v1
    v_and_b32 v21, 7, v0
    v_lshrrev_b32 v22, 3, v0
    v_lshlrev_b32 v28, 4, v21
    v_lshl_add_u32 v28, v22, 9, v28
    v_mul_u32_u24 v30, 272, v22
    v_and_b32 v23, 3, v0
    v_lshl_add_u32 v30, v23, 4, v30
    v_bfe_u32 v29, v0, 2, 1
    v_lshl_add_u32 v30, v29, 3, v30
    s_lshl_b32 s40, s56, 6
    s_add_u32 s40, s40, 150784
    v_add_u32 v30, s40, v30
    v_mul_u32_u24 v31, 272, v21
    v_add3_u32 v31, v31, v27, v12
    v_lshlrev_b32 v21, 5, v21
    v_lshlrev_b32 v29, 6, v29
    v_lshl_add_u32 v29, v1, 4, v29
    s_lshl_b32 s61, s30, 12
    s_lshl_b32 s54, s56, 7
    s_add_u32 s61, s61, s54
    s_add_u32 s61, s61, 327680
    s_lshl_b32 s53, s31, 9
    s_add_u32 s53, s53, s61
    s_lshl_b32 s54, s30, 7
    s_lshl_b32 s55, s31, 14
    s_add_u32 s54, s54, s55
    s_lshl_b32 s55, s56, 12
    s_add_u32 s54, s54, s55
    s_add_u32 s54, s54, 1048576
    s_mov_b32 s48, 0x00010001
    s_mov_b32 s49, s48
    s_mov_b32 s50, 0x00110011
    s_mov_b32 s51, s50
    s_waitcnt lgkmcnt(0)
    s_load_dword s34, s[28:29], 0
    s_mov_b64 s[36:37], s[28:29]
L_spin_4:
    s_sleep 4
    ds_read_b32 v14, v12 offset:0
    s_waitcnt lgkmcnt(0)
    v_cmp_le_i32 vcc, s41, v14
    s_cbranch_vccz L_spin_4
    ds_read_b128 v[32:35], v8 offset:0
    ds_read_b128 v[36:39], v9 offset:0
    ds_read_b128 v[40:43], v10 offset:0
    ds_read_b128 v[44:47], v11 offset:0
    ds_read_b128 v[48:51], v8 offset:4096
    ds_read_b128 v[52:55], v9 offset:4096
    ds_read_b128 v[56:59], v10 offset:4096
    ds_read_b128 v[60:63], v11 offset:4096
    ds_read_b128 v[64:67], v8 offset:8192
    ds_read_b128 v[68:71], v9 offset:8192
    ds_read_b128 v[72:75], v10 offset:8192
    ds_read_b128 v[76:79], v11 offset:8192
    ds_read_b128 v[80:83], v8 offset:12288
    ds_read_b128 v[84:87], v9 offset:12288
    ds_read_b128 v[88:91], v10 offset:12288
    ds_read_b128 v[92:95], v11 offset:12288
    s_mul_i32 s34, s34, 1664525
    s_add_u32 s34, s34, 1013904223
L_spin_5:
    s_sleep 1
    ds_read_b32 v14, v12 offset:256
    s_waitcnt lgkmcnt(0)
    v_cmp_ne_u32 vcc, -1, v14
    s_cbranch_vccz L_spin_5
    v_readfirstlane_b32 s57, v14
    ds_read_b128 v[96:99], v13 offset:512
    ds_read_b128 v[100:103], v13 offset:576
    ds_read_b128 v[104:107], v13 offset:640
    ds_read_b128 v[108:111], v13 offset:704
    s_waitcnt lgkmcnt(3)
    v_mfma_f32_16x16x32_bf16 v[112:115], v[96:99], v[32:35], 0
    v_mfma_f32_16x16x32_bf16 v[116:119], v[96:99], v[48:51], 0
    v_mfma_f32_16x16x32_bf16 v[120:123], v[96:99], v[64:67], 0
    v_mfma_f32_16x16x32_bf16 v[124:127], v[96:99], v[80:83], 0
    s_waitcnt lgkmcnt(2)
    v_mfma_f32_16x16x32_bf16 v[112:115], v[100:103], v[36:39], v[112:115]
    v_mfma_f32_16x16x32_bf16 v[116:119], v[100:103], v[52:55], v[116:119]
    v_mfma_f32_16x16x32_bf16 v[120:123], v[100:103], v[68:71], v[120:123]
    v_mfma_f32_16x16x32_bf16 v[124:127], v[100:103], v[84:87], v[124:127]
    s_waitcnt lgkmcnt(1)
    v_mfma_f32_16x16x32_bf16 v[112:115], v[104:107], v[40:43], v[112:115]
    v_mfma_f32_16x16x32_bf16 v[116:119], v[104:107], v[56:59], v[116:119]
    v_mfma_f32_16x16x32_bf16 v[120:123], v[104:107], v[72:75], v[120:123]
    v_mfma_f32_16x16x32_bf16 v[124:127], v[104:107], v[88:91], v[124:127]
    s_waitcnt lgkmcnt(0)
    v_mfma_f32_16x16x32_bf16 v[112:115], v[108:111], v[44:47], v[112:115]
    v_mfma_f32_16x16x32_bf16 v[116:119], v[108:111], v[60:63], v[116:119]
    v_mfma_f32_16x16x32_bf16 v[120:123], v[108:111], v[76:79], v[120:123]
    v_mfma_f32_16x16x32_bf16 v[124:127], v[108:111], v[92:95], v[124:127]
    v_mov_b32 v130, s34
    v_mov_b32 v134, s34
    v_mov_b32 v136, s34
    v_lshrrev_b32 v137, 8, v136
    v_lshrrev_b32 v138, 16, v136
    v_lshrrev_b32 v139, 24, v136
    v_cndmask_b32 v16, v112, v116, s[42:43]
    v_cndmask_b32 v16, v16, v120, s[44:45]
    v_cndmask_b32 v16, v16, v124, s[46:47]
    s_mov_b32 s42, 0xff
    s_mov_b32 s43, s42
    v_cvt_pk_bf16_f32 v16, v16, v16
    v_lshlrev_b32 v16, 16, v16
    v_mul_f32 v16, 0x3db504f3, v16
    v_cvt_pk_bf16_f32 v16, v16, v16
    v_lshlrev_b32 v16, 16, v16
    v_mul_f32 v16, 0x3fb8aa3b, v16
    v_mov_b32 v18, v16
    s_nop 1
    v_max_f32_dpp v18, v18, v18 quad_perm:[1,0,3,2] row_mask:0xf bank_mask:0xf
    s_nop 1
    v_max_f32_dpp v18, v18, v18 quad_perm:[2,3,0,1] row_mask:0xf bank_mask:0xf
    s_nop 1
    v_max_f32_dpp v18, v18, v18 row_ror:4 row_mask:0xf bank_mask:0xf
    s_nop 1
    v_max_f32_dpp v18, v18, v18 row_ror:8 row_mask:0xf bank_mask:0xf
    v_mov_b32 v17, v18
    s_nop 1
    v_permlane16_swap_b32 v17, v18
    v_max_f32 v18, v18, v17
    v_mov_b32 v17, v18
    s_nop 1
    v_permlane32_swap_b32 v17, v18
    v_max_f32 v18, v18, v17
    s_mov_b64 exec, 1
    ds_write_b32 v20, v18 offset:272
    s_mov_b64 exec, -1
L_spin_6:
    ds_read_b128 v[32:35], v12 offset:272
    s_waitcnt lgkmcnt(0)
    v_max3_u32 v14, v32, v33, v34
    v_max_u32 v14, v14, v35
    v_cmp_ne_u32 vcc, -1, v14
    s_cbranch_vccz L_spin_6
    v_max3_f32 v131, v32, v33, v34
    v_max_f32 v131, v131, v35
    v_sub_f32 v16, v16, v131
    v_exp_f32 v19, v16
    s_nop 0
    v_cvt_pk_bf16_f32 v16, v19, v19
    ds_write_b16 v15, v16
    v_add_f32_dpp v19, v19, v19 quad_perm:[1,0,3,2] row_mask:0xf bank_mask:0xf
    s_nop 1
    v_add_f32_dpp v19, v19, v19 quad_perm:[2,3,0,1] row_mask:0xf bank_mask:0xf
    s_nop 1
    v_add_f32_dpp v19, v19, v19 row_ror:4 row_mask:0xf bank_mask:0xf
    s_nop 1
    v_add_f32_dpp v19, v19, v19 row_ror:8 row_mask:0xf bank_mask:0xf
    v_mov_b32 v17, v19
    s_nop 1
    v_permlane16_swap_b32 v17, v19
    v_add_f32 v19, v19, v17
    v_mov_b32 v17, v19
    s_nop 1
    v_permlane32_swap_b32 v17, v19
    v_add_f32 v19, v19, v17
    s_mov_b64 exec, 1
    ds_write_b32 v20, v19 offset:288
    s_mov_b64 exec, -1
L_spin_7:
    ds_read_b128 v[32:35], v12 offset:288
    s_waitcnt lgkmcnt(0)
    v_max3_u32 v14, v32, v33, v34
    v_max_u32 v14, v14, v35
    v_cmp_ne_u32 vcc, -1, v14
    s_cbranch_vccz L_spin_7
    ds_read_b128 v[144:147], v13 offset:768
    ds_read_b128 v[148:151], v13 offset:832
    ds_read_b128 v[152:155], v13 offset:896
    ds_read_b128 v[156:159], v13 offset:960
    ds_read_b128 v[160:163], v13 offset:1024
    ds_read_b128 v[164:167], v13 offset:1088
    ds_read_b128 v[168:171], v13 offset:1152
    ds_read_b128 v[172:175], v13 offset:1216
    v_add_f32 v135, v32, v33
    v_add_f32 v14, v34, v35
    v_add_f32 v135, v135, v14
    s_waitcnt lgkmcnt(0)
    s_barrier
    ds_read_b64_tr_b16 v[32:33], v24 offset:0
    ds_read_b64_tr_b16 v[34:35], v24 offset:1024
    ds_read_b64_tr_b16 v[36:37], v25 offset:0
    ds_read_b64_tr_b16 v[38:39], v25 offset:1024
    ds_read_b64_tr_b16 v[40:41], v24 offset:8192
    ds_read_b64_tr_b16 v[42:43], v24 offset:9216
    ds_read_b64_tr_b16 v[44:45], v25 offset:8192
    ds_read_b64_tr_b16 v[46:47], v25 offset:9216
    ds_read_b64_tr_b16 v[48:49], v24 offset:16384
    ds_read_b64_tr_b16 v[50:51], v24 offset:17408
    ds_read_b64_tr_b16 v[52:53], v25 offset:16384
    ds_read_b64_tr_b16 v[54:55], v25 offset:17408
    s_waitcnt lgkmcnt(10)
    v_mfma_f32_16x16x32_bf16 v[112:115], v[32:35], v[144:147], 0
    s_waitcnt lgkmcnt(8)
    v_mfma_f32_16x16x32_bf16 v[116:119], v[36:39], v[144:147], 0
    s_waitcnt lgkmcnt(6)
    v_mfma_f32_16x16x32_bf16 v[112:115], v[40:43], v[148:151], v[112:115]
    s_waitcnt lgkmcnt(4)
    v_mfma_f32_16x16x32_bf16 v[116:119], v[44:47], v[148:151], v[116:119]
    s_waitcnt lgkmcnt(2)
    v_mfma_f32_16x16x32_bf16 v[112:115], v[48:51], v[152:155], v[112:115]
    s_waitcnt lgkmcnt(0)
    v_mfma_f32_16x16x32_bf16 v[116:119], v[52:55], v[152:155], v[116:119]
    ds_read_b64_tr_b16 v[32:33], v24 offset:24576
    ds_read_b64_tr_b16 v[34:35], v24 offset:25600
    ds_read_b64_tr_b16 v[36:37], v25 offset:24576
    ds_read_b64_tr_b16 v[38:39], v25 offset:25600
    ds_read_b64_tr_b16 v[40:41], v24 offset:32768
    ds_read_b64_tr_b16 v[42:43], v24 offset:33792
    ds_read_b64_tr_b16 v[44:45], v25 offset:32768
    ds_read_b64_tr_b16 v[46:47], v25 offset:33792
    ds_read_b64_tr_b16 v[48:49], v24 offset:40960
    ds_read_b64_tr_b16 v[50:51], v24 offset:41984
    ds_read_b64_tr_b16 v[52:53], v25 offset:40960
    ds_read_b64_tr_b16 v[54:55], v25 offset:41984
    s_waitcnt lgkmcnt(10)
    v_mfma_f32_16x16x32_bf16 v[112:115], v[32:35], v[156:159], v[112:115]
    s_waitcnt lgkmcnt(8)
    v_mfma_f32_16x16x32_bf16 v[116:119], v[36:39], v[156:159], v[116:119]
    s_waitcnt lgkmcnt(6)
    v_mfma_f32_16x16x32_bf16 v[112:115], v[40:43], v[160:163], v[112:115]
    s_waitcnt lgkmcnt(4)
    v_mfma_f32_16x16x32_bf16 v[116:119], v[44:47], v[160:163], v[116:119]
    s_waitcnt lgkmcnt(2)
    v_mfma_f32_16x16x32_bf16 v[112:115], v[48:51], v[164:167], v[112:115]
    s_waitcnt lgkmcnt(0)
    v_mfma_f32_16x16x32_bf16 v[116:119], v[52:55], v[164:167], v[116:119]
    s_barrier
    ds_read_b64_tr_b16 v[32:33], v24 offset:49152
    ds_read_b64_tr_b16 v[34:35], v24 offset:50176
    ds_read_b64_tr_b16 v[36:37], v25 offset:49152
    ds_read_b64_tr_b16 v[38:39], v25 offset:50176
    ds_read_b64_tr_b16 v[40:41], v24 offset:57344
    ds_read_b64_tr_b16 v[42:43], v24 offset:58368
    ds_read_b64_tr_b16 v[44:45], v25 offset:57344
    ds_read_b64_tr_b16 v[46:47], v25 offset:58368
    s_waitcnt lgkmcnt(6)
    v_mfma_f32_16x16x32_bf16 v[112:115], v[32:35], v[168:171], v[112:115]
    s_waitcnt lgkmcnt(4)
    v_mfma_f32_16x16x32_bf16 v[116:119], v[36:39], v[168:171], v[116:119]
    s_waitcnt lgkmcnt(2)
    v_mfma_f32_16x16x32_bf16 v[112:115], v[40:43], v[172:175], v[112:115]
    s_waitcnt lgkmcnt(0)
    v_mfma_f32_16x16x32_bf16 v[116:119], v[44:47], v[172:175], v[116:119]
    s_cmp_lg_u32 s57, 1
    s_mov_b64 exec, s[48:49]
    s_nop 3
    v_cvt_pk_bf16_f32 v128, v112, v113
    v_cvt_pk_bf16_f32 v129, v114, v115
    s_cbranch_scc1 L_o_wt
    buffer_store_dwordx4 v[128:131], v27, s[36:39], s53 offen
    v_cvt_pk_bf16_f32 v132, v116, v117
    v_cvt_pk_bf16_f32 v133, v118, v119
    buffer_store_dwordx4 v[132:135], v27, s[36:39], s53 offen offset:64
L_o_pub:
    s_mov_b64 exec, -1
    s_mov_b32 s60, 0
    s_mov_b64 s[58:59], -1
    buffer_load_dwordx4 v[32:35], v28, s[36:39], s61 offen sc1
    s_barrier
    buffer_load_dwordx4 v[52:55], v28, s[36:39], s61 offen sc1
    ds_read_b64_tr_b16 v[64:65], v26 offset:0
    ds_read_b64_tr_b16 v[66:67], v26 offset:2048
    ds_read_b64_tr_b16 v[68:69], v26 offset:4096
    ds_read_b64_tr_b16 v[70:71], v26 offset:6144
    ds_read_b64_tr_b16 v[72:73], v26 offset:8192
    ds_read_b64_tr_b16 v[74:75], v26 offset:10240
    ds_read_b64_tr_b16 v[76:77], v26 offset:12288
    ds_read_b64_tr_b16 v[78:79], v26 offset:14336
L_o_chk:
    s_waitcnt vmcnt(1)
    v_cmpx_eq_u32 vcc, s34, v34
    ds_write_b64 v30, v[32:33]
    v_mov_b32 v14, v35
    s_andn2_b64 s[58:59], s[58:59], exec
    s_cbranch_scc0 L_o_go
    s_mov_b64 exec, s[58:59]
    buffer_load_dwordx4 v[32:35], v28, s[36:39], s61 offen sc1
    s_waitcnt vmcnt(1)
    v_cmpx_eq_u32 vcc, s34, v54
    ds_write_b64 v30, v[52:53]
    v_mov_b32 v14, v55
    s_andn2_b64 s[58:59], s[58:59], exec
    s_cbranch_scc0 L_o_go
    s_mov_b64 exec, s[58:59]
    buffer_load_dwordx4 v[52:55], v28, s[36:39], s61 offen sc1
    s_add_u32 s60, s60, 1
    s_cmp_lt_u32 s60, 200000
    s_cbranch_scc1 L_o_chk
L_o_go:
    s_mov_b64 exec, -1
    ds_bpermute_b32 v16, v21, v14
    ds_bpermute_b32 v17, v21, v14 offset:16
    s_waitcnt lgkmcnt(2)
    s_barrier
    ds_read_b128 v[36:39], v31 offset:1280
    ds_read_b128 v[40:43], v31 offset:1344
    ds_read_b128 v[44:47], v31 offset:1408
    ds_read_b128 v[48:51], v31 offset:1472
    s_waitcnt lgkmcnt(4)
    v_max_f32_dpp v18, v16, v16 quad_perm:[1,0,3,2] row_mask:0xf bank_mask:0xf
    s_nop 1
    v_max_f32_dpp v18, v18, v18 quad_perm:[2,3,0,1] row_mask:0xf bank_mask:0xf
    v_sub_f32 v16, v16, v18
    v_exp_f32 v16, v16
    s_waitcnt lgkmcnt(3)
    v_mfma_f32_16x16x32_bf16 v[80:83], v[64:67], v[36:39], 0
    v_mul_f32 v17, v16, v17
    s_waitcnt lgkmcnt(2)
    v_mfma_f32_16x16x32_bf16 v[80:83], v[68:71], v[40:43], v[80:83]
    v_add_f32_dpp v17, v17, v17 quad_perm:[1,0,3,2] row_mask:0xf bank_mask:0xf
    s_waitcnt lgkmcnt(1)
    v_mfma_f32_16x16x32_bf16 v[80:83], v[72:75], v[44:47], v[80:83]
    v_add_f32_dpp v17, v17, v17 quad_perm:[2,3,0,1] row_mask:0xf bank_mask:0xf
    s_waitcnt lgkmcnt(0)
    v_mfma_f32_16x16x32_bf16 v[80:83], v[76:79], v[48:51], v[80:83]
    v_rcp_f32 v17, v17
    s_nop 0
    v_mul_f32 v16, v16, v17
    s_nop 4
    v_pk_mul_f32 v[80:81], v[80:81], v[16:17] op_sel_hi:[1,0]
    v_pk_mul_f32 v[82:83], v[82:83], v[16:17] op_sel_hi:[1,0]
    s_nop 0
    v_add_f32_dpp v80, v80, v80 quad_perm:[1,0,3,2] row_mask:0xf bank_mask:0xf
    v_add_f32_dpp v81, v81, v81 quad_perm:[1,0,3,2] row_mask:0xf bank_mask:0xf
    v_add_f32_dpp v82, v82, v82 quad_perm:[1,0,3,2] row_mask:0xf bank_mask:0xf
    v_add_f32_dpp v83, v83, v83 quad_perm:[1,0,3,2] row_mask:0xf bank_mask:0xf
    v_add_f32_dpp v80, v80, v80 quad_perm:[2,3,0,1] row_mask:0xf bank_mask:0xf
    v_add_f32_dpp v81, v81, v81 quad_perm:[2,3,0,1] row_mask:0xf bank_mask:0xf
    v_add_f32_dpp v82, v82, v82 quad_perm:[2,3,0,1] row_mask:0xf bank_mask:0xf
    v_add_f32_dpp v83, v83, v83 quad_perm:[2,3,0,1] row_mask:0xf bank_mask:0xf
    v_bfi_b32 v80, s42, v136, v80
    v_bfi_b32 v81, s42, v137, v81
    v_bfi_b32 v82, s42, v138, v82
    v_bfi_b32 v83, s42, v139, v83
    s_mov_b64 exec, s[50:51]
    buffer_store_dwordx4 v[80:83], v29, s[36:39], s54 offen sc1
    s_waitcnt vmcnt(0)
    s_barrier
    s_endpgm
L_gwave:
    s_barrier
    s_waitcnt lgkmcnt(0)
    s_load_dword s34, s[28:29], 0
    s_mov_b64 s[36:37], s[28:29]
    v_mov_b32 v18, 0
    s_mov_b64 s[40:41], s[16:17]
    s_mov_b32 s42, 2752
    s_mov_b32 s43, 0x20000
    s_mov_b64 s[52:53], s[18:19]
    s_mov_b32 s54, 2752
    s_mov_b32 s55, 0x20000
    buffer_load_dwordx4 v[64:67], v3, s[40:43], 0 offen offset:0
    buffer_load_dwordx4 v[68:71], v3, s[40:43], 0 offen offset:1024
    buffer_load_dwordx4 v[72:75], v3, s[40:43], 0 offen offset:2048
    buffer_load_dwordx4 v[76:79], v3, s[52:55], 0 offen offset:0
    buffer_load_dwordx4 v[80:83], v3, s[52:55], 0 offen offset:1024
    buffer_load_dwordx4 v[84:87], v3, s[52:55], 0 offen offset:2048
    s_mov_b64 s[40:41], s[20:21]
    s_mov_b64 s[52:53], s[22:23]
    s_mov_b32 s54, 2
    s_mov_b32 s55, 0x20000
    buffer_load_dwordx4 v[88:91], v3, s[40:43], 0 offen offset:0
    buffer_load_dwordx4 v[92:95], v3, s[40:43], 0 offen offset:1024
    buffer_load_dwordx4 v[96:99], v3, s[40:43], 0 offen offset:2048
    buffer_load_ushort v48, v18, s[52:55], 0 offen
    s_lshl_b32 s52, s30, 2
    s_add_u32 s52, s52, s33
    s_lshl_b32 s53, s32, 10
    s_add_u32 s54, s53, 147456
    v_lshl_add_u32 v40, v0, 1, s52
    v_add_u32 v41, 1, v40
    v_and_b32 v40, 127, v40
    v_and_b32 v41, 127, v41
    v_lshl_add_u32 v40, v40, 3, s54
    v_lshl_add_u32 v41, v41, 3, s54
    s_lshl_b32 s52, s52, 3
    s_add_u32 s53, s53, s52
    v_lshl_add_u32 v15, v0, 2, s53
    v_add_u32 v14, 147456, v15
    s_mov_b32 s44, 0xbdd2d3e8
    s_mov_b32 s45, s44
    s_mov_b32 s46, 1.0
    s_mov_b32 s47, 1.0
    v_mov_b32 v30, 0xc0135761
    v_mov_b32 v31, v30
    v_and_b32 v49, 1, v0
    v_cmp_eq_u32 s[48:49], 1, v49
    v_lshlrev_b32 v19, 7, v0
    s_lshl_b32 s61, s30, 12
    s_lshl_b32 s52, s31, 4
    s_add_u32 s61, s61, s52
    s_add_u32 s61, s61, 1048576
L_spin_8:
    s_sleep 4
    ds_read_b32 v8, v12 offset:264
    s_waitcnt lgkmcnt(0)
    v_cmp_le_i32 vcc, 1, v8
    s_cbranch_vccz L_spin_8
    ds_read_b64 v[8:9], v40
    ds_read_b64 v[10:11], v41
    ds_read_b32 v5, v14
    s_mov_b32 s52, 0
    s_waitcnt lgkmcnt(0)
    s_mul_i32 s34, s34, 1664525
    s_add_u32 s34, s34, 1013904223
    v_lshlrev_b32 v4, 16, v5
    v_and_b32 v5, s35, v5
L_g_ln:
    v_lshlrev_b32 v50, 16, v8
    v_and_b32 v51, s35, v8
    v_lshlrev_b32 v52, 16, v9
    v_and_b32 v53, s35, v9
    v_lshlrev_b32 v54, 16, v10
    v_and_b32 v55, s35, v10
    v_lshlrev_b32 v56, 16, v11
    v_and_b32 v57, s35, v11
    v_pk_add_f32 v[20:21], v[50:51], v[52:53]
    v_pk_add_f32 v[22:23], v[54:55], v[56:57]
    v_pk_add_f32 v[20:21], v[20:21], v[22:23]
    v_add_f32 v36, v20, v21
    s_nop 1
    v_add_f32_dpp v36, v36, v36 quad_perm:[1,0,3,2] row_mask:0xf bank_mask:0xf
    s_nop 1
    v_add_f32_dpp v36, v36, v36 quad_perm:[2,3,0,1] row_mask:0xf bank_mask:0xf
    s_nop 1
    v_add_f32_dpp v36, v36, v36 row_ror:4 row_mask:0xf bank_mask:0xf
    s_nop 1
    v_add_f32_dpp v36, v36, v36 row_ror:8 row_mask:0xf bank_mask:0xf
    v_mov_b32 v37, v36
    s_nop 1
    v_permlane16_swap_b32 v37, v36
    v_add_f32 v36, v36, v37
    v_mov_b32 v37, v36
    s_nop 1
    v_permlane32_swap_b32 v37, v36
    v_add_f32 v36, v36, v37
    v_mul_f32 v36, 0x3b000000, v36
    v_pk_add_f32 v[20:21], v[50:51], v[36:37] op_sel_hi:[1,0] neg_lo:[0,1] neg_hi:[0,1]
    v_pk_add_f32 v[22:23], v[52:53], v[36:37] op_sel_hi:[1,0] neg_lo:[0,1] neg_hi:[0,1]
    v_pk_add_f32 v[24:25], v[54:55], v[36:37] op_sel_hi:[1,0] neg_lo:[0,1] neg_hi:[0,1]
    v_pk_add_f32 v[26:27], v[56:57], v[36:37] op_sel_hi:[1,0] neg_lo:[0,1] neg_hi:[0,1]
    v_pk_mul_f32 v[20:21], v[20:21], v[20:21]
    v_pk_mul_f32 v[22:23], v[22:23], v[22:23]
    v_pk_fma_f32 v[20:21], v[24:25], v[24:25], v[20:21]
    v_pk_fma_f32 v[22:23], v[26:27], v[26:27], v[22:23]
    v_pk_add_f32 v[20:21], v[20:21], v[22:23]
    v_add_f32 v38, v20, v21
    s_nop 1
    v_add_f32_dpp v38, v38, v38 quad_perm:[1,0,3,2] row_mask:0xf bank_mask:0xf
    s_nop 1
    v_add_f32_dpp v38, v38, v38 quad_perm:[2,3,0,1] row_mask:0xf bank_mask:0xf
    s_nop 1
    v_add_f32_dpp v38, v38, v38 row_ror:4 row_mask:0xf bank_mask:0xf
    s_nop 1
    v_add_f32_dpp v38, v38, v38 row_ror:8 row_mask:0xf bank_mask:0xf
    v_mov_b32 v37, v38
    s_nop 1
    v_permlane16_swap_b32 v37, v38
    v_add_f32 v38, v38, v37
    v_mov_b32 v37, v38
    s_nop 1
    v_permlane32_swap_b32 v37, v38
    v_add_f32 v38, v38, v37
    v_mul_f32 v38, 0x3b000000, v38
    v_cvt_pk_bf16_f32 v37, v36, v38
    v_lshlrev_b32 v40, 16, v37
    v_and_b32 v42, s35, v37
    v_add_f32 v42, 0x3727c5ac, v42
    v_cvt_pk_bf16_f32 v37, v42, v42
    v_lshlrev_b32 v42, 16, v37
    v_sqrt_f32 v42, v42
    s_nop 0
    v_cvt_pk_bf16_f32 v37, v42, v42
    v_lshlrev_b32 v42, 16, v37
    v_rcp_f32 v42, v42
    v_pk_add_f32 v[50:51], v[50:51], v[40:41] op_sel_hi:[1,0] neg_lo:[0,1] neg_hi:[0,1]
    v_pk_add_f32 v[52:53], v[52:53], v[40:41] op_sel_hi:[1,0] neg_lo:[0,1] neg_hi:[0,1]
    v_pk_add_f32 v[54:55], v[54:55], v[40:41] op_sel_hi:[1,0] neg_lo:[0,1] neg_hi:[0,1]
    v_pk_add_f32 v[56:57], v[56:57], v[40:41] op_sel_hi:[1,0] neg_lo:[0,1] neg_hi:[0,1]
    v_cvt_pk_bf16_f32 v8, v50, v51
    v_cvt_pk_bf16_f32 v9, v52, v53
    v_cvt_pk_bf16_f32 v10, v54, v55
    v_cvt_pk_bf16_f32 v11, v56, v57
    v_lshlrev_b32 v50, 16, v8
    v_and_b32 v51, s35, v8
    v_lshlrev_b32 v52, 16, v9
    v_and_b32 v53, s35, v9
    v_lshlrev_b32 v54, 16, v10
    v_and_b32 v55, s35, v10
    v_lshlrev_b32 v56, 16, v11
    v_and_b32 v57, s35, v11
    v_pk_mul_f32 v[50:51], v[50:51], v[42:43] op_sel_hi:[1,0]
    v_pk_mul_f32 v[52:53], v[52:53], v[42:43] op_sel_hi:[1,0]
    v_pk_mul_f32 v[54:55], v[54:55], v[42:43] op_sel_hi:[1,0]
    v_pk_mul_f32 v[56:57], v[56:57], v[42:43] op_sel_hi:[1,0]
    v_cvt_pk_bf16_f32 v8, v50, v51
    v_cvt_pk_bf16_f32 v9, v52, v53
    v_cvt_pk_bf16_f32 v10, v54, v55
    v_cvt_pk_bf16_f32 v11, v56, v57
    s_add_u32 s52, s52, 1
    s_cmp_lt_u32 s52, 2
    s_cbranch_scc1 L_g_ln
    v_readfirstlane_b32 s57, v8
    v_readfirstlane_b32 s59, v9
    s_lshl_b32 s56, s57, 16
    s_and_b32 s57, s57, s35
    s_lshl_b32 s58, s59, 16
    s_and_b32 s59, s59, s35
    s_waitcnt vmcnt(0)
    v_lshlrev_b32 v100, 16, v64
    v_and_b32 v101, s35, v64
    v_lshlrev_b32 v102, 16, v65
    v_and_b32 v103, s35, v65
    v_lshlrev_b32 v104, 16, v66
    v_and_b32 v105, s35, v66
    v_lshlrev_b32 v106, 16, v67
    v_and_b32 v107, s35, v67
    v_lshlrev_b32 v108, 16, v68
    v_and_b32 v109, s35, v68
    v_lshlrev_b32 v110, 16, v69
    v_and_b32 v111, s35, v69
    v_lshlrev_b32 v112, 16, v70
    v_and_b32 v113, s35, v70
    v_lshlrev_b32 v114, 16, v71
    v_and_b32 v115, s35, v71
    v_lshlrev_b32 v116, 16, v72
    v_and_b32 v117, s35, v72
    v_lshlrev_b32 v118, 16, v73
    v_and_b32 v119, s35, v73
    v_lshlrev_b32 v120, 16, v74
    v_and_b32 v121, s35, v74
    v_lshlrev_b32 v122, 16, v75
    v_and_b32 v123, s35, v75
    v_lshlrev_b32 v124, 16, v76
    v_and_b32 v125, s35, v76
    v_lshlrev_b32 v126, 16, v77
    v_and_b32 v127, s35, v77
    v_lshlrev_b32 v128, 16, v78
    v_and_b32 v129, s35, v78
    v_lshlrev_b32 v130, 16, v79
    v_and_b32 v131, s35, v79
    v_lshlrev_b32 v132, 16, v80
    v_and_b32 v133, s35, v80
    v_lshlrev_b32 v134, 16, v81
    v_and_b32 v135, s35, v81
    v_lshlrev_b32 v136, 16, v82
    v_and_b32 v137, s35, v82
    v_lshlrev_b32 v138, 16, v83
    v_and_b32 v139, s35, v83
    v_lshlrev_b32 v140, 16, v84
    v_and_b32 v141, s35, v84
    v_lshlrev_b32 v142, 16, v85
    v_and_b32 v143, s35, v85
    v_lshlrev_b32 v144, 16, v86
    v_and_b32 v145, s35, v86
    v_lshlrev_b32 v146, 16, v87
    v_and_b32 v147, s35, v87
    v_lshlrev_b32 v148, 16, v88
    v_and_b32 v149, s35, v88
    v_lshlrev_b32 v150, 16, v89
    v_and_b32 v151, s35, v89
    v_lshlrev_b32 v152, 16, v90
    v_and_b32 v153, s35, v90
    v_lshlrev_b32 v154, 16, v91
    v_and_b32 v155, s35, v91
    v_lshlrev_b32 v156, 16, v92
    v_and_b32 v157, s35, v92
    v_lshlrev_b32 v158, 16, v93
    v_and_b32 v159, s35, v93
    v_lshlrev_b32 v160, 16, v94
    v_and_b32 v161, s35, v94
    v_lshlrev_b32 v162, 16, v95
    v_and_b32 v163, s35, v95
    v_lshlrev_b32 v164, 16, v96
    v_and_b32 v165, s35, v96
    v_lshlrev_b32 v166, 16, v97
    v_and_b32 v167, s35, v97
    v_lshlrev_b32 v168, 16, v98
    v_and_b32 v169, s35, v98
    v_lshlrev_b32 v170, 16, v99
    v_and_b32 v171, s35, v99
    s_mov_b32 s52, 0
L_g_mlp:
    v_pk_fma_f32 v[64:65], v[100:101], s[56:57], v[124:125] op_sel_hi:[1,0,1]
    v_pk_fma_f32 v[66:67], v[102:103], s[56:57], v[126:127] op_sel_hi:[1,0,1]
    v_pk_fma_f32 v[68:69], v[104:105], s[56:57], v[128:129] op_sel_hi:[1,0,1]
    v_pk_fma_f32 v[70:71], v[106:107], s[56:57], v[130:131] op_sel_hi:[1,0,1]
    v_pk_mul_f32 v[72:73], v[64:65], v[64:65]
    v_pk_mul_f32 v[74:75], v[66:67], v[66:67]
    v_pk_mul_f32 v[76:77], v[68:69], v[68:69]
    v_pk_mul_f32 v[78:79], v[70:71], v[70:71]
    v_pk_fma_f32 v[72:73], v[72:73], s[44:45], v[30:31]
    v_pk_fma_f32 v[74:75], v[74:75], s[44:45], v[30:31]
    v_pk_fma_f32 v[76:77], v[76:77], s[44:45], v[30:31]
    v_pk_fma_f32 v[78:79], v[78:79], s[44:45], v[30:31]
    v_pk_mul_f32 v[72:73], v[72:73], v[64:65]
    v_pk_mul_f32 v[74:75], v[74:75], v[66:67]
    v_pk_mul_f32 v[76:77], v[76:77], v[68:69]
    v_pk_mul_f32 v[78:79], v[78:79], v[70:71]
    v_exp_f32 v72, v72
    v_exp_f32 v73, v73
    v_exp_f32 v74, v74
    v_exp_f32 v75, v75
    v_exp_f32 v76, v76
    v_exp_f32 v77, v77
    v_exp_f32 v78, v78
    v_exp_f32 v79, v79
    v_pk_mul_f32 v[64:65], v[64:65], v[148:149]
    v_pk_mul_f32 v[66:67], v[66:67], v[150:151]
    v_pk_mul_f32 v[68:69], v[68:69], v[152:153]
    v_pk_mul_f32 v[70:71], v[70:71], v[154:155]
    v_pk_add_f32 v[72:73], v[72:73], s[46:47]
    v_pk_add_f32 v[74:75], v[74:75], s[46:47]
    v_pk_add_f32 v[76:77], v[76:77], s[46:47]
    v_pk_add_f32 v[78:79], v[78:79], s[46:47]
    v_rcp_f32 v72, v72
    v_rcp_f32 v73, v73
    v_rcp_f32 v74, v74
    v_rcp_f32 v75, v75
    v_rcp_f32 v76, v76
    v_rcp_f32 v77, v77
    v_rcp_f32 v78, v78
    v_rcp_f32 v79, v79
    v_pk_mul_f32 v[80:81], v[64:65], v[72:73]
    v_pk_mul_f32 v[82:83], v[66:67], v[74:75]
    v_pk_mul_f32 v[84:85], v[68:69], v[76:77]
    v_pk_mul_f32 v[86:87], v[70:71], v[78:79]
    v_pk_fma_f32 v[64:65], v[108:109], s[56:57], v[132:133] op_sel_hi:[1,0,1]
    v_pk_fma_f32 v[66:67], v[110:111], s[56:57], v[134:135] op_sel_hi:[1,0,1]
    v_pk_fma_f32 v[68:69], v[112:113], s[56:57], v[136:137] op_sel_hi:[1,0,1]
    v_pk_fma_f32 v[70:71], v[114:115], s[56:57], v[138:139] op_sel_hi:[1,0,1]
    v_pk_mul_f32 v[72:73], v[64:65], v[64:65]
    v_pk_mul_f32 v[74:75], v[66:67], v[66:67]
    v_pk_mul_f32 v[76:77], v[68:69], v[68:69]
    v_pk_mul_f32 v[78:79], v[70:71], v[70:71]
    v_pk_fma_f32 v[72:73], v[72:73], s[44:45], v[30:31]
    v_pk_fma_f32 v[74:75], v[74:75], s[44:45], v[30:31]
    v_pk_fma_f32 v[76:77], v[76:77], s[44:45], v[30:31]
    v_pk_fma_f32 v[78:79], v[78:79], s[44:45], v[30:31]
    v_pk_mul_f32 v[72:73], v[72:73], v[64:65]
    v_pk_mul_f32 v[74:75], v[74:75], v[66:67]
    v_pk_mul_f32 v[76:77], v[76:77], v[68:69]
    v_pk_mul_f32 v[78:79], v[78:79], v[70:71]
    v_exp_f32 v72, v72
    v_exp_f32 v73, v73
    v_exp_f32 v74, v74
    v_exp_f32 v75, v75
    v_exp_f32 v76, v76
    v_exp_f32 v77, v77
    v_exp_f32 v78, v78
    v_exp_f32 v79, v79
    v_pk_mul_f32 v[64:65], v[64:65], v[156:157]
    v_pk_mul_f32 v[66:67], v[66:67], v[158:159]
    v_pk_mul_f32 v[68:69], v[68:69], v[160:161]
    v_pk_mul_f32 v[70:71], v[70:71], v[162:163]
    v_pk_add_f32 v[72:73], v[72:73], s[46:47]
    v_pk_add_f32 v[74:75], v[74:75], s[46:47]
    v_pk_add_f32 v[76:77], v[76:77], s[46:47]
    v_pk_add_f32 v[78:79], v[78:79], s[46:47]
    v_rcp_f32 v72, v72
    v_rcp_f32 v73, v73
    v_rcp_f32 v74, v74
    v_rcp_f32 v75, v75
    v_rcp_f32 v76, v76
    v_rcp_f32 v77, v77
    v_rcp_f32 v78, v78
    v_rcp_f32 v79, v79
    v_pk_fma_f32 v[80:81], v[64:65], v[72:73], v[80:81]
    v_pk_fma_f32 v[82:83], v[66:67], v[74:75], v[82:83]
    v_pk_fma_f32 v[84:85], v[68:69], v[76:77], v[84:85]
    v_pk_fma_f32 v[86:87], v[70:71], v[78:79], v[86:87]
    v_pk_fma_f32 v[64:65], v[116:117], s[56:57], v[140:141] op_sel_hi:[1,0,1]
    v_pk_fma_f32 v[66:67], v[118:119], s[56:57], v[142:143] op_sel_hi:[1,0,1]
    v_pk_fma_f32 v[68:69], v[120:121], s[56:57], v[144:145] op_sel_hi:[1,0,1]
    v_pk_fma_f32 v[70:71], v[122:123], s[56:57], v[146:147] op_sel_hi:[1,0,1]
    v_pk_mul_f32 v[72:73], v[64:65], v[64:65]
    v_pk_mul_f32 v[74:75], v[66:67], v[66:67]
    v_pk_mul_f32 v[76:77], v[68:69], v[68:69]
    v_pk_mul_f32 v[78:79], v[70:71], v[70:71]
    v_pk_fma_f32 v[72:73], v[72:73], s[44:45], v[30:31]
    v_pk_fma_f32 v[74:75], v[74:75], s[44:45], v[30:31]
    v_pk_fma_f32 v[76:77], v[76:77], s[44:45], v[30:31]
    v_pk_fma_f32 v[78:79], v[78:79], s[44:45], v[30:31]
    v_pk_mul_f32 v[72:73], v[72:73], v[64:65]
    v_pk_mul_f32 v[74:75], v[74:75], v[66:67]
    v_pk_mul_f32 v[76:77], v[76:77], v[68:69]
    v_pk_mul_f32 v[78:79], v[78:79], v[70:71]
    v_exp_f32 v72, v72
    v_exp_f32 v73, v73
    v_exp_f32 v74, v74
    v_exp_f32 v75, v75
    v_exp_f32 v76, v76
    v_exp_f32 v77, v77
    v_exp_f32 v78, v78
    v_exp_f32 v79, v79
    v_pk_mul_f32 v[64:65], v[64:65], v[164:165]
    v_pk_mul_f32 v[66:67], v[66:67], v[166:167]
    v_pk_mul_f32 v[68:69], v[68:69], v[168:169]
    v_pk_mul_f32 v[70:71], v[70:71], v[170:171]
    v_pk_add_f32 v[72:73], v[72:73], s[46:47]
    v_pk_add_f32 v[74:75], v[74:75], s[46:47]
    v_pk_add_f32 v[76:77], v[76:77], s[46:47]
    v_pk_add_f32 v[78:79], v[78:79], s[46:47]
    v_rcp_f32 v72, v72
    v_rcp_f32 v73, v73
    v_rcp_f32 v74, v74
    v_rcp_f32 v75, v75
    v_rcp_f32 v76, v76
    v_rcp_f32 v77, v77
    v_rcp_f32 v78, v78
    v_rcp_f32 v79, v79
    v_pk_fma_f32 v[80:81], v[64:65], v[72:73], v[80:81]
    v_pk_fma_f32 v[82:83], v[66:67], v[74:75], v[82:83]
    v_pk_fma_f32 v[84:85], v[68:69], v[76:77], v[84:85]
    v_pk_fma_f32 v[86:87], v[70:71], v[78:79], v[86:87]
    v_pk_add_f32 v[80:81], v[80:81], v[82:83]
    v_pk_add_f32 v[84:85], v[84:85], v[86:87]
    v_mov_b32 v20, v21
    v_mov_b32 v21, v22
    v_pk_add_f32 v[80:81], v[80:81], v[84:85]
    v_mov_b32 v22, v23
    s_mov_b32 s56, s57
    s_mov_b32 s57, s58
    s_mov_b32 s58, s59
    v_add_f32 v23, v80, v81
    s_add_u32 s52, s52, 1
    s_cmp_lt_u32 s52, 4
    s_cbranch_scc1 L_g_mlp
    v_add_f32_dpp v20, v20, v20 quad_perm:[1,0,3,2] row_mask:0xf bank_mask:0xf
    v_add_f32_dpp v21, v21, v21 quad_perm:[1,0,3,2] row_mask:0xf bank_mask:0xf
    v_add_f32_dpp v22, v22, v22 quad_perm:[1,0,3,2] row_mask:0xf bank_mask:0xf
    v_add_f32_dpp v23, v23, v23 quad_perm:[1,0,3,2] row_mask:0xf bank_mask:0xf
    v_add_f32_dpp v20, v20, v20 quad_perm:[2,3,0,1] row_mask:0xf bank_mask:0xf
    v_add_f32_dpp v21, v21, v21 quad_perm:[2,3,0,1] row_mask:0xf bank_mask:0xf
    v_add_f32_dpp v22, v22, v22 quad_perm:[2,3,0,1] row_mask:0xf bank_mask:0xf
    v_add_f32_dpp v23, v23, v23 quad_perm:[2,3,0,1] row_mask:0xf bank_mask:0xf
    v_add_f32_dpp v20, v20, v20 row_ror:4 row_mask:0xf bank_mask:0xf
    v_add_f32_dpp v21, v21, v21 row_ror:4 row_mask:0xf bank_mask:0xf
    v_add_f32_dpp v22, v22, v22 row_ror:4 row_mask:0xf bank_mask:0xf
    v_add_f32_dpp v23, v23, v23 row_ror:4 row_mask:0xf bank_mask:0xf
    v_add_f32_dpp v20, v20, v20 row_ror:8 row_mask:0xf bank_mask:0xf
    v_add_f32_dpp v21, v21, v21 row_ror:8 row_mask:0xf bank_mask:0xf
    v_add_f32_dpp v22, v22, v22 row_ror:8 row_mask:0xf bank_mask:0xf
    v_add_f32_dpp v23, v23, v23 row_ror:8 row_mask:0xf bank_mask:0xf
    v_mov_b32 v24, v20
    v_mov_b32 v25, v21
    v_mov_b32 v26, v22
    v_mov_b32 v27, v23
    v_permlane16_swap_b32 v24, v20
    v_permlane16_swap_b32 v25, v21
    v_permlane16_swap_b32 v26, v22
    v_permlane16_swap_b32 v27, v23
    v_add_f32 v20, v20, v24
    v_add_f32 v21, v21, v25
    v_add_f32 v22, v22, v26
    v_add_f32 v23, v23, v27
    v_mov_b32 v24, v20
    v_mov_b32 v25, v21
    v_mov_b32 v26, v22
    v_mov_b32 v27, v23
    v_permlane32_swap_b32 v24, v20
    v_permlane32_swap_b32 v25, v21
    v_permlane32_swap_b32 v26, v22
    v_permlane32_swap_b32 v27, v23
    v_add_f32 v20, v20, v24
    v_add_f32 v21, v21, v25
    v_add_f32 v22, v22, v26
    v_add_f32 v23, v23, v27
    v_cndmask_b32 v6, v20, v22, s[48:49]
    v_cndmask_b32 v7, v21, v23, s[48:49]
    v_lshlrev_b32 v48, 16, v48
    v_cvt_pk_bf16_f32 v8, v6, v7
    v_lshlrev_b32 v6, 16, v8
    v_and_b32 v7, s35, v8
    v_add_f32 v6, v6, v48
    v_add_f32 v7, v7, v48
    v_cvt_pk_bf16_f32 v8, v6, v7
    v_lshlrev_b32 v6, 16, v8
    v_and_b32 v7, s35, v8
    v_mul_f32 v8, 0xbfb8aa3b, v6
    v_mul_f32 v9, 0xbfb8aa3b, v7
    v_exp_f32 v8, v8
    v_exp_f32 v9, v9
    v_add_f32 v8, 1.0, v8
    v_add_f32 v9, 1.0, v9
    v_rcp_f32 v8, v8
    v_rcp_f32 v9, v9
    v_mul_f32 v6, v6, v8
    v_mul_f32 v7, v7, v9
    v_cvt_pk_bf16_f32 v8, v6, v7
    v_lshlrev_b32 v6, 16, v8
    v_and_b32 v7, s35, v8
    v_mov_b32 v17, s34
    s_mov_b64 s[40:41], s[24:25]
    s_mov_b32 s42, 2048
    s_mov_b32 s43, 0x20000
    s_mov_b32 s60, 0
    s_mov_b32 s58, -1
    s_mov_b32 s59, 0
    s_mov_b64 exec, s[58:59]
    s_barrier
    s_barrier
    s_barrier
    s_barrier
    s_barrier
    buffer_load_dwordx4 v[64:67], v19, s[36:39], s61 offen sc1
L_sx:
    s_waitcnt vmcnt(0)
    v_cmpx_eq_u32_sdwa vcc, v64, v17 src0_sel:BYTE_0 src1_sel:BYTE_0
    v_cmpx_eq_u32_sdwa vcc, v65, v17 src0_sel:BYTE_0 src1_sel:BYTE_1
    v_cmpx_eq_u32_sdwa vcc, v66, v17 src0_sel:BYTE_0 src1_sel:BYTE_2
    v_cmpx_eq_u32_sdwa vcc, v67, v17 src0_sel:BYTE_0 src1_sel:BYTE_3
    v_mov_b64 v[32:33], v[64:65]
    v_mov_b64 v[34:35], v[66:67]
    s_andn2_b64 s[58:59], s[58:59], exec
    s_cbranch_scc0 L_sx_go
    s_mov_b64 exec, s[58:59]
    buffer_load_dwordx4 v[64:67], v19, s[36:39], s61 offen sc1
    s_add_u32 s60, s60, 1
    s_cmp_lt_u32 s60, 200000
    s_cbranch_scc1 L_sx
L_sx_go:
    s_mov_b64 exec, -1
    v_add_f32_dpp v32, v32, v32 quad_perm:[1,0,3,2] row_mask:0xf bank_mask:0xf
    v_add_f32_dpp v33, v33, v33 quad_perm:[1,0,3,2] row_mask:0xf bank_mask:0xf
    v_add_f32_dpp v34, v34, v34 quad_perm:[1,0,3,2] row_mask:0xf bank_mask:0xf
    v_add_f32_dpp v35, v35, v35 quad_perm:[1,0,3,2] row_mask:0xf bank_mask:0xf
    v_cndmask_b32 v32, v32, v34, s[48:49]
    v_cndmask_b32 v34, v33, v35, s[48:49]
    s_nop 0
    v_add_f32_dpp v32, v32, v32 quad_perm:[2,3,0,1] row_mask:0xf bank_mask:0xf
    v_add_f32_dpp v34, v34, v34 quad_perm:[2,3,0,1] row_mask:0xf bank_mask:0xf
    s_nop 0
    v_add_f32_dpp v32, v32, v32 row_ror:4 row_mask:0xf bank_mask:0xf
    v_add_f32_dpp v34, v34, v34 row_ror:4 row_mask:0xf bank_mask:0xf
    s_nop 0
    v_add_f32_dpp v32, v32, v32 row_ror:8 row_mask:0xf bank_mask:0xf
    v_add_f32_dpp v34, v34, v34 row_ror:8 row_mask:0xf bank_mask:0xf
    v_mov_b32 v33, v32
    v_mov_b32 v35, v34
    s_nop 0
    v_permlane16_swap_b32 v33, v32
    v_permlane16_swap_b32 v35, v34
    v_add_f32 v32, v32, v33
    v_add_f32 v34, v34, v35
    v_cvt_pk_bf16_f32 v8, v32, v34
    v_lshlrev_b32 v32, 16, v8
    v_and_b32 v34, s35, v8
    v_mul_f32 v32, v32, v6
    v_mul_f32 v34, v34, v7
    v_cvt_pk_bf16_f32 v8, v32, v34
    v_lshlrev_b32 v32, 16, v8
    v_and_b32 v34, s35, v8
    v_add_f32 v32, v32, v4
    v_add_f32 v34, v34, v5
    v_cvt_pk_bf16_f32 v8, v32, v34
    s_mov_b64 exec, 3
    buffer_store_dword v8, v15, s[40:43], 0 offen
    s_cmp_lg_u32 s2, 0
    s_cbranch_scc1 L_fin
    s_mov_b64 exec, 1
    buffer_store_dword v17, v18, s[36:39], 0 offen
L_fin:
L_end:
    s_endpgm
L_q_slow:
    s_mov_b64 exec, -1
    s_xor_b32 s61, s61, 524288
    v_xor_b32 v184, s55, v184
    s_cmp_lg_u32 s60, 48
    s_cbranch_scc1 L_q_slow2
    v_mov_b32 v25, 2
    v_lshrrev_b32 v185, 8, v184
    v_lshrrev_b32 v186, 16, v184
    v_lshrrev_b32 v187, 24, v184
    v_bfi_b32 v180, s56, v184, v180
    v_bfi_b32 v181, s56, v185, v181
    v_bfi_b32 v182, s56, v186, v182
    v_bfi_b32 v183, s56, v187, v183
    s_add_u32 s53, s53, 524288
    s_mov_b32 exec_hi, 0
    buffer_store_dwordx4 v[180:183], v188, s[36:39], s53 offen sc1
L_q_slow2:
    s_cmp_ge_u32 s60, 200000
    s_cbranch_scc1 L_q_go
    s_branch L_q_rty
L_o_wt:
    buffer_store_dwordx4 v[128:131], v27, s[36:39], s53 offen sc1
    v_cvt_pk_bf16_f32 v132, v116, v117
    v_cvt_pk_bf16_f32 v133, v118, v119
    buffer_store_dwordx4 v[132:135], v27, s[36:39], s53 offen offset:64 sc1
    s_branch L_o_pub
L_code_end:
.section .rodata,"a"
.p2align 6
.amdhsa_kernel recurrent_scan__sliding_block_cached__mixer_token_mlp__decode_kernel
  .amdhsa_next_free_vgpr 192
  .amdhsa_next_free_sgpr 102
  .amdhsa_accum_offset 192
  .amdhsa_group_segment_fixed_size 0
  .amdhsa_kernarg_size 104
  .amdhsa_user_sgpr_count 2
  .amdhsa_user_sgpr_kernarg_segment_ptr 1
  .amdhsa_system_sgpr_workgroup_id_x 1
  .amdhsa_float_denorm_mode_32 3
.end_amdhsa_kernel
```
